```python
import torch

def _softmax(x, axis=-1):
    return torch.softmax(x, dim=axis)
def _gelu(x):
    return torch.nn.functional.gelu(x, approximate="tanh")
def _silu(x):
    return torch.nn.functional.silu(x)
def _sigmoid(x):
    return torch.sigmoid(x)
def _layernorm(x, axis=-1, eps=1e-5):
    m = x.mean(dim=axis, keepdim=True)
    v = x.var(dim=axis, keepdim=True, unbiased=False)
    return (x - m) / torch.sqrt(v + eps)
def _scatter_add(tgt, idx, src, axis=0):
    return tgt.clone().index_add_(axis, idx, src)
def _segment_sum(src, seg, n):
    out = torch.zeros((n,) + src.shape[1:], dtype=src.dtype)
    return out.index_add_(0, seg, src)
def _pad(x, pw):
    flat = tuple(v for pair in reversed(pw) for v in pair)
    return torch.nn.functional.pad(x, flat)

kernel_name = 'recurrent_scan__sliding_block_cached__swiglu_ffn__decode'

def setup_inputs():

    _w = (lambda a: (lambda t: t.to(torch.bfloat16) if t.is_floating_point() else t)(torch.as_tensor(a)))
    def _A_setup():
        B, Sq, D = 1, 1, 576
        Hq, Hkv, Sk, Dh = 32, 16, 8192, 128
        assert Hq % Hkv == 0, (Hq, Hkv)
        return {
            "x": _w((lambda *s: torch.randn(*s, dtype=torch.bfloat16) * 0.05)(B, Sq, D)),
            "k_cache": _w((lambda *s: torch.randn(*s, dtype=torch.bfloat16) * 0.8)(B, Hkv, Sk, Dh)),
            "v_cache": _w((lambda *s: torch.randn(*s, dtype=torch.bfloat16) * 0.2)(B, Hkv, Sk, Dh)),
            "wq": _w((lambda *s: torch.randn(*s, dtype=torch.bfloat16) * 0.8)(D, Hq * Dh) * (D ** -0.5)),
            "wo": _w((lambda *s: torch.randn(*s, dtype=torch.bfloat16) * 0.2)(Hq * Dh, D) * ((Hq * Dh) ** -0.5)),
        }
    _A_in = _A_setup()

    def _B_setup():
        B, S, D, F = 1, 1, 576, 4608
        return {
            "x": _w((lambda *s: torch.randn(*s, dtype=torch.bfloat16) * 0.05)(B, S, D)),
            "w_gate": _w((lambda *s: torch.randn(*s, dtype=torch.bfloat16) * 0.1)(D, F)),
            "w_up": _w((lambda *s: torch.randn(*s, dtype=torch.bfloat16) * 0.1)(D, F)),
            "w_down": _w((lambda *s: torch.randn(*s, dtype=torch.bfloat16) * 0.1)(F, D)),
        }
    _B_in = _B_setup()

    return {
        "A_x": _A_in["x"],
        "A_k_cache": _A_in["k_cache"],
        "A_v_cache": _A_in["v_cache"],
        "A_wq": _A_in["wq"],
        "A_wo": _A_in["wo"],
        "B_x": _B_in["x"],
        "B_w_gate": _B_in["w_gate"],
        "B_w_up": _B_in["w_up"],
        "B_w_down": _B_in["w_down"],
    }

def reference(A_x, A_k_cache, A_v_cache, A_wq, A_wo, B_x, B_w_gate, B_w_up, B_w_down):
    def _A_ref(x, k_cache, v_cache, wq, wo):
        B, Sq, D = x.shape
        Hq, Dh = 32, 128
        Hkv, Sk = k_cache.shape[1], k_cache.shape[2]
        W = min(4096, max(256, Sk // 4))
        rep = Hq // Hkv
        q = (lambda x, *d: x.permute(*d))((x @ wq).reshape(B, Sq, Hq, Dh), 0, 2, 1, 3)
        k = (lambda x, n, axis: torch.repeat_interleave(x, n, dim=axis))(k_cache[:, :, Sk - W:, :], rep, axis=1)
        v = (lambda x, n, axis: torch.repeat_interleave(x, n, dim=axis))(v_cache[:, :, Sk - W:, :], rep, axis=1)
        scores = torch.einsum("bhqd,bhkd->bhqk", q, k) * (Dh ** -0.5)
        p = _softmax(scores, axis=-1)
        o = torch.einsum("bhqk,bhkd->bhqd", p, v)
        return (lambda x, *d: x.permute(*d))(o, 0, 2, 1, 3).reshape(B, Sq, Hq * Dh) @ wo

    def _B_ref(x, w_gate, w_up, w_down):
        g = _silu(x @ w_gate)
        u = x @ w_up
        return (g * u) @ w_down

    x = A_x
    xn = _layernorm(x, axis=-1)
    s = _A_ref(xn, A_k_cache, A_v_cache, A_wq, A_wo)
    g = _silu(_B_ref(xn, B_w_gate, B_w_up, B_w_down))
    return x + s * g
```

```asm
; @launch grid=(256,1,1) block=(576,1,1) lds=59392
.amdgcn_target "amdgcn-amd-amdhsa--gfx950"
.text
.globl recurrent_scan__sliding_block_cached__swiglu_ffn__decode_kernel
.p2align 8
.type recurrent_scan__sliding_block_cached__swiglu_ffn__decode_kernel,@function
recurrent_scan__sliding_block_cached__swiglu_ffn__decode_kernel:
  s_cmp_ge_u32 s2, 256
  s_cbranch_scc1 L_exit
  s_getpc_b64 s[48:49]
L_pfbase:
  s_load_dwordx8 s[4:11], s[0:1], 0
  s_load_dwordx2 s[12:13], s[0:1], 32
  s_load_dwordx8 s[16:23], s[0:1], 48
  s_load_dwordx4 s[24:27], s[0:1], 80
  v_lshrrev_b32 v1, 6, v0
  v_and_b32 v2, 63, v0
  v_readfirstlane_b32 s28, v1
  v_lshlrev_b32 v3, 4, v0
  s_mov_b32 s50, L_code_end-L_pfbase
  s_mov_b32 s51, 0x20000
  buffer_load_dwordx4 v[116:119], v3, s[48:51], 0 offen
  s_mov_b32 s29, 0xffff0000
  s_mov_b32 s70, 0x3db504f3
  s_mov_b32 s71, 0x3fb8aa3b
  s_waitcnt lgkmcnt(0)
  s_mov_b32 s40, s26
  s_mov_b32 s41, s27
  s_mov_b32 s42, 268435456
  s_mov_b32 s43, 0x20000
  s_mov_b32 s36, s24
  s_mov_b32 s37, s25
  s_mov_b32 s38, 256
  s_mov_b32 s39, 0x20000
  s_or_b32 s50, s2, s28
  s_cmp_lg_u32 s50, 0
  s_cbranch_scc1 L_nopub
  s_memrealtime s[30:31]
  s_waitcnt lgkmcnt(0)
  s_or_b32 s30, s30, 1
  v_mov_b32 v8, s30
  v_mov_b32 v9, s31
  v_mov_b32 v10, 0
  s_mov_b64 exec, 1
  buffer_store_dwordx2 v[8:9], v10, s[36:39], 0 offen sc1
  s_mov_b64 exec, -1
L_nopub:
  s_cmp_ge_u32 s2, 208
  s_cbranch_scc1 L_p1_skip
  s_mov_b32 s48, 0
  s_cmp_ge_u32 s2, 52
  s_addc_u32 s48, s48, 0
  s_cmp_ge_u32 s2, 104
  s_addc_u32 s48, s48, 0
  s_cmp_ge_u32 s2, 156
  s_addc_u32 s48, s48, 0
  s_mul_i32 s49, s48, 52
  s_sub_u32 s49, s2, s49
  v_mul_u32_u24 v5, 18, v2
  v_mul_u32_u24 v6, 36, v2
  s_mov_b32 s44, s4
  s_mov_b32 s45, s5
  s_mov_b32 s46, 1152
  s_mov_b32 s47, 0x20000
  s_cmp_lg_u32 s28, 0
  s_cbranch_scc1 L_p1_a
  buffer_load_ushort v8, v5, s[44:47], 0 offen offset:0
  buffer_load_ushort v9, v5, s[44:47], 0 offen offset:2
  buffer_load_ushort v10, v5, s[44:47], 0 offen offset:4
  buffer_load_ushort v11, v5, s[44:47], 0 offen offset:6
  buffer_load_ushort v12, v5, s[44:47], 0 offen offset:8
  buffer_load_ushort v13, v5, s[44:47], 0 offen offset:10
  buffer_load_ushort v14, v5, s[44:47], 0 offen offset:12
  buffer_load_ushort v15, v5, s[44:47], 0 offen offset:14
  buffer_load_ushort v16, v5, s[44:47], 0 offen offset:16
L_p1_a:
  s_mov_b32 s32, s10
  s_mov_b32 s33, s11
  s_mov_b32 s50, 8192
  s_mov_b32 s52, 0
  s_cmp_ge_u32 s49, 16
  s_cselect_b32 s32, s16, s32
  s_cselect_b32 s33, s17, s33
  s_cselect_b32 s50, 9216, s50
  s_cselect_b32 s52, 16, s52
  s_cmp_ge_u32 s49, 34
  s_cselect_b32 s32, s18, s32
  s_cselect_b32 s33, s19, s33
  s_cselect_b32 s52, 34, s52
  s_sub_u32 s51, s49, s52
  s_mul_i32 s34, s50, 576
  s_mov_b32 s35, 0x20000
  s_mul_i32 s54, s48, 144
  s_lshl_b32 s55, s28, 4
  s_add_u32 s53, s54, s55
  s_mul_i32 s54, s53, s50
  s_lshl_b32 s55, s51, 9
  s_add_u32 s54, s54, s55
  s_add_u32 s55, s54, s50
  s_add_u32 s56, s55, s50
  s_add_u32 s57, s56, s50
  s_add_u32 s58, s57, s50
  s_add_u32 s59, s58, s50
  s_add_u32 s60, s59, s50
  s_add_u32 s61, s60, s50
  s_lshl_b32 s62, s50, 3
  v_and_b32 v3, 31, v2
  v_lshlrev_b32 v3, 4, v3
  v_lshrrev_b32 v4, 5, v2
  v_mul_lo_u32 v4, v4, s62
  v_add_u32 v3, v3, v4
  s_barrier
  buffer_load_dwordx4 v[32:35], v3, s[32:35], s54 offen nt
  buffer_load_dwordx4 v[36:39], v3, s[32:35], s55 offen nt
  buffer_load_dwordx4 v[40:43], v3, s[32:35], s56 offen nt
  buffer_load_dwordx4 v[44:47], v3, s[32:35], s57 offen nt
  buffer_load_dwordx4 v[48:51], v3, s[32:35], s58 offen nt
  buffer_load_dwordx4 v[52:55], v3, s[32:35], s59 offen nt
  buffer_load_dwordx4 v[56:59], v3, s[32:35], s60 offen nt
  buffer_load_dwordx4 v[60:63], v3, s[32:35], s61 offen nt
  v_lshrrev_b32 v7, 5, v2
  v_lshlrev_b32 v7, 5, v7
  s_lshl_b32 s63, s53, 2
  v_add_u32 v7, s63, v7
  v_and_b32 v80, 31, v2
  v_lshlrev_b32 v80, 5, v80
  v_lshrrev_b32 v81, 5, v2
  v_lshlrev_b32 v81, 4, v81
  v_add_u32 v80, v80, v81
  s_lshl_b32 s63, s28, 10
  s_add_u32 s63, s63, 2304
  v_add_u32 v80, s63, v80
  s_cmp_lg_u32 s28, 0
  s_nop 0
  s_cbranch_scc1 L_p1_b
  s_waitcnt vmcnt(8)
  v_lshlrev_b32 v8, 16, v8
  v_lshlrev_b32 v9, 16, v9
  v_lshlrev_b32 v10, 16, v10
  v_lshlrev_b32 v11, 16, v11
  v_lshlrev_b32 v12, 16, v12
  v_lshlrev_b32 v13, 16, v13
  v_lshlrev_b32 v14, 16, v14
  v_lshlrev_b32 v15, 16, v15
  v_lshlrev_b32 v16, 16, v16
  v_add_f32 v17, v8, v9
  v_add_f32 v17, v17, v10
  v_add_f32 v17, v17, v11
  v_add_f32 v17, v17, v12
  v_add_f32 v17, v17, v13
  v_add_f32 v17, v17, v14
  v_add_f32 v17, v17, v15
  v_add_f32 v17, v17, v16
  s_nop 1
  v_add_f32_dpp v17, v17, v17 row_shr:1 row_mask:0xf bank_mask:0xf bound_ctrl:0
  s_nop 1
  v_add_f32_dpp v17, v17, v17 row_shr:2 row_mask:0xf bank_mask:0xf bound_ctrl:0
  s_nop 1
  v_add_f32_dpp v17, v17, v17 row_shr:4 row_mask:0xf bank_mask:0xf bound_ctrl:0
  s_nop 1
  v_add_f32_dpp v17, v17, v17 row_shr:8 row_mask:0xf bank_mask:0xf bound_ctrl:0
  s_nop 1
  v_add_f32_dpp v17, v17, v17 row_bcast:15 row_mask:0xa bank_mask:0xf
  s_nop 1
  v_add_f32_dpp v17, v17, v17 row_bcast:31 row_mask:0xc bank_mask:0xf
  v_mov_b32 v18, 0x3ae38e39
  v_readlane_b32 s63, v17, 63
  s_nop 1
  v_mul_f32 v19, s63, v18
  v_sub_f32 v20, v8, v19
  v_mul_f32 v22, v20, v20
  v_sub_f32 v20, v9, v19
  v_fmac_f32 v22, v20, v20
  v_sub_f32 v20, v10, v19
  v_fmac_f32 v22, v20, v20
  v_sub_f32 v20, v11, v19
  v_fmac_f32 v22, v20, v20
  v_sub_f32 v20, v12, v19
  v_fmac_f32 v22, v20, v20
  v_sub_f32 v20, v13, v19
  v_fmac_f32 v22, v20, v20
  v_sub_f32 v20, v14, v19
  v_fmac_f32 v22, v20, v20
  v_sub_f32 v20, v15, v19
  v_fmac_f32 v22, v20, v20
  v_sub_f32 v20, v16, v19
  v_fmac_f32 v22, v20, v20
  s_nop 1
  v_add_f32_dpp v22, v22, v22 row_shr:1 row_mask:0xf bank_mask:0xf bound_ctrl:0
  s_nop 1
  v_add_f32_dpp v22, v22, v22 row_shr:2 row_mask:0xf bank_mask:0xf bound_ctrl:0
  s_nop 1
  v_add_f32_dpp v22, v22, v22 row_shr:4 row_mask:0xf bank_mask:0xf bound_ctrl:0
  s_nop 1
  v_add_f32_dpp v22, v22, v22 row_shr:8 row_mask:0xf bank_mask:0xf bound_ctrl:0
  s_nop 1
  v_add_f32_dpp v22, v22, v22 row_bcast:15 row_mask:0xa bank_mask:0xf
  s_nop 1
  v_add_f32_dpp v22, v22, v22 row_bcast:31 row_mask:0xc bank_mask:0xf
  s_nop 0
  v_readlane_b32 s63, v22, 63
  s_nop 1
  v_mul_f32 v22, s63, v18
  v_cvt_pk_bf16_f32 v20, v22, v22
  v_lshlrev_b32 v22, 16, v20
  v_add_f32 v22, 0x3727c5ac, v22
  v_cvt_pk_bf16_f32 v20, v22, v22
  v_lshlrev_b32 v22, 16, v20
  v_sqrt_f32 v23, v22
  s_nop 0
  v_rcp_f32 v20, v23
  v_fma_f32 v21, -v23, v23, v22
  v_mul_f32 v20, 0.5, v20
  v_fma_f32 v23, v21, v20, v23
  v_cvt_pk_bf16_f32 v20, v23, v23
  v_lshlrev_b32 v23, 16, v20
  v_rcp_f32 v72, v23
  v_cvt_pk_bf16_f32 v20, v19, v19
  v_lshlrev_b32 v19, 16, v20
  v_sub_f32 v8, v8, v19
  v_sub_f32 v9, v9, v19
  v_sub_f32 v10, v10, v19
  v_sub_f32 v11, v11, v19
  v_sub_f32 v12, v12, v19
  v_sub_f32 v13, v13, v19
  v_sub_f32 v14, v14, v19
  v_sub_f32 v15, v15, v19
  v_sub_f32 v16, v16, v19
  v_cvt_pk_bf16_f32 v20, v8, v9
  v_lshlrev_b32 v8, 16, v20
  v_and_b32 v9, s29, v20
  v_cvt_pk_bf16_f32 v20, v10, v11
  v_lshlrev_b32 v10, 16, v20
  v_and_b32 v11, s29, v20
  v_cvt_pk_bf16_f32 v20, v12, v13
  v_lshlrev_b32 v12, 16, v20
  v_and_b32 v13, s29, v20
  v_cvt_pk_bf16_f32 v20, v14, v15
  v_lshlrev_b32 v14, 16, v20
  v_and_b32 v15, s29, v20
  v_cvt_pk_bf16_f32 v20, v16, v16
  v_lshlrev_b32 v16, 16, v20
  v_mul_f32 v20, v8, v72
  v_fma_f32 v21, -v20, v23, v8
  v_fma_f32 v8, v21, v72, v20
  v_mul_f32 v20, v9, v72
  v_fma_f32 v21, -v20, v23, v9
  v_fma_f32 v9, v21, v72, v20
  v_mul_f32 v20, v10, v72
  v_fma_f32 v21, -v20, v23, v10
  v_fma_f32 v10, v21, v72, v20
  v_mul_f32 v20, v11, v72
  v_fma_f32 v21, -v20, v23, v11
  v_fma_f32 v11, v21, v72, v20
  v_mul_f32 v20, v12, v72
  v_fma_f32 v21, -v20, v23, v12
  v_fma_f32 v12, v21, v72, v20
  v_mul_f32 v20, v13, v72
  v_fma_f32 v21, -v20, v23, v13
  v_fma_f32 v13, v21, v72, v20
  v_mul_f32 v20, v14, v72
  v_fma_f32 v21, -v20, v23, v14
  v_fma_f32 v14, v21, v72, v20
  v_mul_f32 v20, v15, v72
  v_fma_f32 v21, -v20, v23, v15
  v_fma_f32 v15, v21, v72, v20
  v_mul_f32 v20, v16, v72
  v_fma_f32 v21, -v20, v23, v16
  v_fma_f32 v16, v21, v72, v20
  v_cvt_pk_bf16_f32 v20, v8, v9
  v_lshlrev_b32 v8, 16, v20
  v_and_b32 v9, s29, v20
  v_cvt_pk_bf16_f32 v20, v10, v11
  v_lshlrev_b32 v10, 16, v20
  v_and_b32 v11, s29, v20
  v_cvt_pk_bf16_f32 v20, v12, v13
  v_lshlrev_b32 v12, 16, v20
  v_and_b32 v13, s29, v20
  v_cvt_pk_bf16_f32 v20, v14, v15
  v_lshlrev_b32 v14, 16, v20
  v_and_b32 v15, s29, v20
  v_cvt_pk_bf16_f32 v20, v16, v16
  v_lshlrev_b32 v16, 16, v20
  ds_write_b32 v6, v8 offset:0
  ds_write_b32 v6, v9 offset:4
  ds_write_b32 v6, v10 offset:8
  ds_write_b32 v6, v11 offset:12
  ds_write_b32 v6, v12 offset:16
  ds_write_b32 v6, v13 offset:20
  ds_write_b32 v6, v14 offset:24
  ds_write_b32 v6, v15 offset:28
  ds_write_b32 v6, v16 offset:32
  s_mov_b32 s44, s24
  s_mov_b32 s45, s25
  s_mov_b32 s46, 256
  s_mov_b32 s47, 0x20000
  v_mov_b32 v86, 0
  buffer_load_dwordx2 v[84:85], v86, s[44:47], 0 offen sc1
  s_waitcnt lgkmcnt(0)
L_p1_b:
  s_barrier
  ds_read_b128 v[24:27], v7 offset:0
  ds_read_b128 v[28:31], v7 offset:16
  s_cmp_lg_u32 s28, 0
  s_cbranch_scc1 L_p1_c
  s_waitcnt vmcnt(0)
L_p1_c:
  s_waitcnt lgkmcnt(0)
  s_waitcnt vmcnt(7)
  v_lshlrev_b32 v72, 16, v32
  v_and_b32 v73, s29, v32
  v_mul_f32 v64, v24, v72
  v_mul_f32 v65, v24, v73
  v_lshlrev_b32 v74, 16, v33
  v_and_b32 v75, s29, v33
  v_mul_f32 v66, v24, v74
  v_mul_f32 v67, v24, v75
  v_lshlrev_b32 v72, 16, v34
  v_and_b32 v73, s29, v34
  v_mul_f32 v68, v24, v72
  v_mul_f32 v69, v24, v73
  v_lshlrev_b32 v74, 16, v35
  v_and_b32 v75, s29, v35
  v_mul_f32 v70, v24, v74
  v_mul_f32 v71, v24, v75
  s_waitcnt vmcnt(6)
  v_lshlrev_b32 v72, 16, v36
  v_and_b32 v73, s29, v36
  v_fmac_f32 v64, v25, v72
  v_fmac_f32 v65, v25, v73
  v_lshlrev_b32 v74, 16, v37
  v_and_b32 v75, s29, v37
  v_fmac_f32 v66, v25, v74
  v_fmac_f32 v67, v25, v75
  v_lshlrev_b32 v72, 16, v38
  v_and_b32 v73, s29, v38
  v_fmac_f32 v68, v25, v72
  v_fmac_f32 v69, v25, v73
  v_lshlrev_b32 v74, 16, v39
  v_and_b32 v75, s29, v39
  v_fmac_f32 v70, v25, v74
  v_fmac_f32 v71, v25, v75
  s_waitcnt vmcnt(5)
  v_lshlrev_b32 v72, 16, v40
  v_and_b32 v73, s29, v40
  v_fmac_f32 v64, v26, v72
  v_fmac_f32 v65, v26, v73
  v_lshlrev_b32 v74, 16, v41
  v_and_b32 v75, s29, v41
  v_fmac_f32 v66, v26, v74
  v_fmac_f32 v67, v26, v75
  v_lshlrev_b32 v72, 16, v42
  v_and_b32 v73, s29, v42
  v_fmac_f32 v68, v26, v72
  v_fmac_f32 v69, v26, v73
  v_lshlrev_b32 v74, 16, v43
  v_and_b32 v75, s29, v43
  v_fmac_f32 v70, v26, v74
  v_fmac_f32 v71, v26, v75
  s_waitcnt vmcnt(4)
  v_lshlrev_b32 v72, 16, v44
  v_and_b32 v73, s29, v44
  v_fmac_f32 v64, v27, v72
  v_fmac_f32 v65, v27, v73
  v_lshlrev_b32 v74, 16, v45
  v_and_b32 v75, s29, v45
  v_fmac_f32 v66, v27, v74
  v_fmac_f32 v67, v27, v75
  v_lshlrev_b32 v72, 16, v46
  v_and_b32 v73, s29, v46
  v_fmac_f32 v68, v27, v72
  v_fmac_f32 v69, v27, v73
  v_lshlrev_b32 v74, 16, v47
  v_and_b32 v75, s29, v47
  v_fmac_f32 v70, v27, v74
  v_fmac_f32 v71, v27, v75
  s_waitcnt vmcnt(3)
  v_lshlrev_b32 v72, 16, v48
  v_and_b32 v73, s29, v48
  v_fmac_f32 v64, v28, v72
  v_fmac_f32 v65, v28, v73
  v_lshlrev_b32 v74, 16, v49
  v_and_b32 v75, s29, v49
  v_fmac_f32 v66, v28, v74
  v_fmac_f32 v67, v28, v75
  v_lshlrev_b32 v72, 16, v50
  v_and_b32 v73, s29, v50
  v_fmac_f32 v68, v28, v72
  v_fmac_f32 v69, v28, v73
  v_lshlrev_b32 v74, 16, v51
  v_and_b32 v75, s29, v51
  v_fmac_f32 v70, v28, v74
  v_fmac_f32 v71, v28, v75
  s_waitcnt vmcnt(2)
  v_lshlrev_b32 v72, 16, v52
  v_and_b32 v73, s29, v52
  v_fmac_f32 v64, v29, v72
  v_fmac_f32 v65, v29, v73
  v_lshlrev_b32 v74, 16, v53
  v_and_b32 v75, s29, v53
  v_fmac_f32 v66, v29, v74
  v_fmac_f32 v67, v29, v75
  v_lshlrev_b32 v72, 16, v54
  v_and_b32 v73, s29, v54
  v_fmac_f32 v68, v29, v72
  v_fmac_f32 v69, v29, v73
  v_lshlrev_b32 v74, 16, v55
  v_and_b32 v75, s29, v55
  v_fmac_f32 v70, v29, v74
  v_fmac_f32 v71, v29, v75
  s_waitcnt vmcnt(1)
  v_lshlrev_b32 v72, 16, v56
  v_and_b32 v73, s29, v56
  v_fmac_f32 v64, v30, v72
  v_fmac_f32 v65, v30, v73
  v_lshlrev_b32 v74, 16, v57
  v_and_b32 v75, s29, v57
  v_fmac_f32 v66, v30, v74
  v_fmac_f32 v67, v30, v75
  v_lshlrev_b32 v72, 16, v58
  v_and_b32 v73, s29, v58
  v_fmac_f32 v68, v30, v72
  v_fmac_f32 v69, v30, v73
  v_lshlrev_b32 v74, 16, v59
  v_and_b32 v75, s29, v59
  v_fmac_f32 v70, v30, v74
  v_fmac_f32 v71, v30, v75
  s_waitcnt vmcnt(0)
  v_lshlrev_b32 v72, 16, v60
  v_and_b32 v73, s29, v60
  v_fmac_f32 v64, v31, v72
  v_fmac_f32 v65, v31, v73
  v_lshlrev_b32 v74, 16, v61
  v_and_b32 v75, s29, v61
  v_fmac_f32 v66, v31, v74
  v_fmac_f32 v67, v31, v75
  v_lshlrev_b32 v72, 16, v62
  v_and_b32 v73, s29, v62
  v_fmac_f32 v68, v31, v72
  v_fmac_f32 v69, v31, v73
  v_lshlrev_b32 v74, 16, v63
  v_and_b32 v75, s29, v63
  v_fmac_f32 v70, v31, v74
  v_fmac_f32 v71, v31, v75
  s_cmp_eq_u32 s28, 0
  s_nop 0
  s_cbranch_scc1 L_kv_skipk1
  s_lshr_b32 s48, s2, 4
  s_and_b32 s49, s2, 15
  s_mov_b32 s32, s6
  s_mov_b32 s33, s7
  s_mov_b32 s34, 33554432
  s_mov_b32 s35, 0x20000
  s_mov_b32 s36, s8
  s_mov_b32 s37, s9
  s_mov_b32 s38, 33554432
  s_mov_b32 s39, 0x20000
  s_sub_u32 s50, s28, 1
  s_lshl_b32 s51, s48, 21
  s_lshl_b32 s52, s49, 15
  s_lshl_b32 s53, s50, 12
  s_add_u32 s51, s51, s52
  s_add_u32 s51, s51, s53
  s_add_u32 s51, s51, 0x180000
  v_and_b32 v3, 15, v2
  v_lshlrev_b32 v3, 8, v3
  v_lshrrev_b32 v5, 4, v2
  v_lshlrev_b32 v4, 4, v5
  v_add_u32 v3, v3, v4
  v_lshlrev_b32 v4, 4, v2
  buffer_load_dwordx4 v[12:15], v3, s[32:35], s51 offen offset:0 nt
  buffer_load_dwordx4 v[16:19], v3, s[32:35], s51 offen offset:64 nt
  buffer_load_dwordx4 v[20:23], v3, s[32:35], s51 offen offset:128 nt
  buffer_load_dwordx4 v[24:27], v3, s[32:35], s51 offen offset:192 nt
L_kv_skipk1:
  v_permlane32_swap_b32 v64, v68
  v_permlane32_swap_b32 v65, v69
  v_permlane32_swap_b32 v66, v70
  v_permlane32_swap_b32 v67, v71
  v_add_f32 v76, v64, v68
  v_add_f32 v77, v65, v69
  v_add_f32 v78, v66, v70
  v_add_f32 v79, v67, v71
  ds_write_b128 v80, v[76:79]
  s_cmp_lg_u32 s28, 0
  s_cbranch_scc1 L_p1_d
  s_mov_b32 s50, 0
  v_mov_b32 v86, 0
L_nonce_chka:
  s_waitcnt vmcnt(0)
  v_readfirstlane_b32 s30, v84
  v_readfirstlane_b32 s31, v85
  s_cmp_lg_u32 s30, 0
  s_nop 3
  s_cbranch_scc1 L_nonce_oka
  s_add_u32 s50, s50, 1
  s_sleep 1
  s_cmp_ge_u32 s50, 400000
  s_cbranch_scc1 L_nonce_oka
  buffer_load_dwordx2 v[84:85], v86, s[44:47], 0 offen sc1
  s_branch L_nonce_chka
L_nonce_oka:
  ds_write_b64 v86, v[84:85] offset:21248
L_p1_d:
  s_waitcnt lgkmcnt(0)
  s_barrier
  s_cmp_lg_u32 s28, 0
  s_cbranch_scc1 L_p1_e
  v_lshlrev_b32 v1, 3, v2
  ds_read_b64 v[32:33], v1 offset:2304
  ds_read_b64 v[34:35], v1 offset:3328
  ds_read_b64 v[36:37], v1 offset:4352
  ds_read_b64 v[38:39], v1 offset:5376
  ds_read_b64 v[40:41], v1 offset:6400
  ds_read_b64 v[42:43], v1 offset:7424
  ds_read_b64 v[44:45], v1 offset:8448
  ds_read_b64 v[46:47], v1 offset:9472
  ds_read_b64 v[48:49], v1 offset:10496
  ds_read_b64 v[50:51], v1 offset:2816
  ds_read_b64 v[52:53], v1 offset:3840
  ds_read_b64 v[54:55], v1 offset:4864
  ds_read_b64 v[56:57], v1 offset:5888
  ds_read_b64 v[58:59], v1 offset:6912
  ds_read_b64 v[60:61], v1 offset:7936
  ds_read_b64 v[62:63], v1 offset:8960
  ds_read_b64 v[64:65], v1 offset:9984
  ds_read_b64 v[66:67], v1 offset:11008
  s_mul_i32 s54, s48, 6656
  s_lshl_b32 s55, s49, 7
  s_add_u32 s54, s54, s55
  s_lshl_b32 s54, s54, 4
  v_lshlrev_b32 v1, 4, v2
  v_mov_b32 v78, s30
  v_mov_b32 v79, s31
  v_mov_b32 v82, s30
  v_mov_b32 v83, s31
  s_waitcnt lgkmcnt(9)
  v_pk_add_f32 v[32:33], v[32:33], v[34:35]
  v_pk_add_f32 v[36:37], v[36:37], v[38:39]
  v_pk_add_f32 v[40:41], v[40:41], v[42:43]
  v_pk_add_f32 v[44:45], v[44:45], v[46:47]
  v_pk_add_f32 v[32:33], v[32:33], v[36:37]
  v_pk_add_f32 v[40:41], v[40:41], v[44:45]
  v_pk_add_f32 v[32:33], v[32:33], v[48:49]
  v_pk_add_f32 v[76:77], v[32:33], v[40:41]
  buffer_store_dwordx4 v[76:79], v1, s[40:43], s54 offen offset:0 sc1
  s_waitcnt lgkmcnt(0)
  v_pk_add_f32 v[50:51], v[50:51], v[52:53]
  v_pk_add_f32 v[54:55], v[54:55], v[56:57]
  v_pk_add_f32 v[58:59], v[58:59], v[60:61]
  v_pk_add_f32 v[62:63], v[62:63], v[64:65]
  v_pk_add_f32 v[50:51], v[50:51], v[54:55]
  v_pk_add_f32 v[58:59], v[58:59], v[62:63]
  v_pk_add_f32 v[50:51], v[50:51], v[66:67]
  v_pk_add_f32 v[80:81], v[50:51], v[58:59]
  buffer_store_dwordx4 v[80:83], v1, s[40:43], s54 offen offset:1024 sc1
  s_nop 1
  s_branch L_p1_e
L_p1_skip:
  s_cmp_eq_u32 s28, 0
  s_cbranch_scc1 L_kv_skipk2
  s_lshr_b32 s48, s2, 4
  s_and_b32 s49, s2, 15
  s_mov_b32 s32, s6
  s_mov_b32 s33, s7
  s_mov_b32 s34, 33554432
  s_mov_b32 s35, 0x20000
  s_mov_b32 s36, s8
  s_mov_b32 s37, s9
  s_mov_b32 s38, 33554432
  s_mov_b32 s39, 0x20000
  s_sub_u32 s50, s28, 1
  s_lshl_b32 s51, s48, 21
  s_lshl_b32 s52, s49, 15
  s_lshl_b32 s53, s50, 12
  s_add_u32 s51, s51, s52
  s_add_u32 s51, s51, s53
  s_add_u32 s51, s51, 0x180000
  v_and_b32 v3, 15, v2
  v_lshlrev_b32 v3, 8, v3
  v_lshrrev_b32 v5, 4, v2
  v_lshlrev_b32 v4, 4, v5
  v_add_u32 v3, v3, v4
  v_lshlrev_b32 v4, 4, v2
  buffer_load_dwordx4 v[12:15], v3, s[32:35], s51 offen offset:0 nt
  buffer_load_dwordx4 v[16:19], v3, s[32:35], s51 offen offset:64 nt
  buffer_load_dwordx4 v[20:23], v3, s[32:35], s51 offen offset:128 nt
  buffer_load_dwordx4 v[24:27], v3, s[32:35], s51 offen offset:192 nt
L_kv_skipk2:
  s_cmp_lg_u32 s28, 0
  s_cbranch_scc1 L_p1_skip_b
  s_mov_b32 s44, s24
  s_mov_b32 s45, s25
  s_mov_b32 s46, 256
  s_mov_b32 s47, 0x20000
  v_mov_b32 v86, 0
  buffer_load_dwordx2 v[84:85], v86, s[44:47], 0 offen sc1
  s_mov_b32 s50, 0
  v_mov_b32 v86, 0
L_nonce_chkb:
  s_waitcnt vmcnt(0)
  v_readfirstlane_b32 s30, v84
  v_readfirstlane_b32 s31, v85
  s_cmp_lg_u32 s30, 0
  s_nop 3
  s_cbranch_scc1 L_nonce_okb
  s_add_u32 s50, s50, 1
  s_sleep 1
  s_cmp_ge_u32 s50, 400000
  s_cbranch_scc1 L_nonce_okb
  buffer_load_dwordx2 v[84:85], v86, s[44:47], 0 offen sc1
  s_branch L_nonce_chkb
L_nonce_okb:
  ds_write_b64 v86, v[84:85] offset:21248
  s_waitcnt lgkmcnt(0)
L_p1_skip_b:
  s_barrier
L_p1_e:
  v_mov_b32 v86, 0
  ds_read_b64 v[84:85], v86 offset:21248
  s_waitcnt lgkmcnt(0)
  v_readfirstlane_b32 s30, v84
  v_readfirstlane_b32 s31, v85
  s_cmp_eq_u32 s28, 0
  s_nop 3
  s_cbranch_scc1 L_kv_skipv1
  s_lshr_b32 s48, s2, 4
  s_and_b32 s49, s2, 15
  s_mov_b32 s32, s6
  s_mov_b32 s33, s7
  s_mov_b32 s34, 33554432
  s_mov_b32 s35, 0x20000
  s_mov_b32 s36, s8
  s_mov_b32 s37, s9
  s_mov_b32 s38, 33554432
  s_mov_b32 s39, 0x20000
  s_sub_u32 s50, s28, 1
  s_lshl_b32 s51, s48, 21
  s_lshl_b32 s52, s49, 15
  s_lshl_b32 s53, s50, 12
  s_add_u32 s51, s51, s52
  s_add_u32 s51, s51, s53
  s_add_u32 s51, s51, 0x180000
  v_and_b32 v3, 15, v2
  v_lshlrev_b32 v3, 8, v3
  v_lshrrev_b32 v5, 4, v2
  v_lshlrev_b32 v4, 4, v5
  v_add_u32 v3, v3, v4
  v_lshlrev_b32 v4, 4, v2
  buffer_load_dwordx4 v[28:31], v4, s[36:39], s51 offen offset:0 nt
  buffer_load_dwordx4 v[32:35], v4, s[36:39], s51 offen offset:1024 nt
  buffer_load_dwordx4 v[36:39], v4, s[36:39], s51 offen offset:2048 nt
  buffer_load_dwordx4 v[40:43], v4, s[36:39], s51 offen offset:3072 nt
L_kv_skipv1:
  s_lshr_b32 s48, s2, 4
  s_and_b32 s49, s2, 15
  s_cmp_eq_u32 s28, 0
  s_cbranch_scc1 L_p2_helper
  s_sub_u32 s50, s28, 1
  v_lshrrev_b32 v5, 4, v2
  v_and_b32 v70, 7, v2
  v_and_b32 v71, 1, v70
  v_lshlrev_b32 v71, 4, v71
  v_mov_b32 v72, 0xffff
  v_lshlrev_b32 v72, v71, v72
  v_lshrrev_b32 v70, 1, v70
  v_cmp_eq_u32 vcc, 0, v70
  s_nop 1
  v_cndmask_b32 v8, 0, v72, vcc
  v_cmp_eq_u32 vcc, 1, v70
  s_nop 1
  v_cndmask_b32 v9, 0, v72, vcc
  v_cmp_eq_u32 vcc, 2, v70
  s_nop 1
  v_cndmask_b32 v10, 0, v72, vcc
  v_cmp_eq_u32 vcc, 3, v70
  s_nop 1
  v_cndmask_b32 v11, 0, v72, vcc
  v_bfe_u32 v6, v2, 3, 1
  v_lshlrev_b32 v6, 6, v6
  v_lshlrev_b32 v70, 2, v5
  v_add_u32 v6, v6, v70
  v_bfe_u32 v73, v2, 2, 1
  v_lshlrev_b32 v73, 8, v73
  v_lshlrev_b32 v70, 4, v5
  v_add_u32 v73, v73, v70
  v_lshrrev_b32 v7, 5, v2
  v_lshlrev_b32 v7, 9, v7
  v_and_b32 v70, 15, v2
  v_lshlrev_b32 v70, 5, v70
  v_add_u32 v7, v7, v70
  v_bfe_u32 v70, v2, 4, 1
  v_lshlrev_b32 v71, 4, v70
  v_add_u32 v7, v7, v71
  s_lshl_b32 s52, s50, 10
  s_add_u32 s52, s52, 12800
  v_add_u32 v7, s52, v7
  v_lshlrev_b32 v69, 3, v70
  s_lshl_b32 s52, s50, 4
  s_add_u32 s52, s52, 20992
  v_add_u32 v69, s52, v69
  s_barrier
  ds_read_b128 v[44:47], v73 offset:12288
  ds_read_b128 v[48:51], v73 offset:12352
  ds_read_b128 v[52:55], v73 offset:12416
  ds_read_b128 v[56:59], v73 offset:12480
  v_lshlrev_b32 v3, 4, v0
  s_mov_b32 s32, s12
  s_mov_b32 s33, s13
  s_mov_b32 s34, 4718592
  s_mov_b32 s35, 0x20000
  s_mov_b32 s36, s20
  s_mov_b32 s37, s21
  s_mul_i32 s56, s2, 20736
  s_add_u32 s38, s56, 20736
  s_mov_b32 s39, 0x20000
  s_mul_i32 s57, s2, 18432
  s_add_u32 s58, s57, 9216
  s_add_u32 s59, s56, 9216
  s_add_u32 s60, s56, 18432
  buffer_load_dwordx4 v[96:99], v3, s[32:35], s57 offen nt
  buffer_load_dwordx4 v[100:103], v3, s[32:35], s58 offen nt
  buffer_load_dwordx4 v[104:107], v3, s[36:39], s56 offen nt
  buffer_load_dwordx4 v[108:111], v3, s[36:39], s59 offen nt
  buffer_load_dwordx4 v[112:115], v3, s[36:39], s60 offen nt
  s_waitcnt vmcnt(9) lgkmcnt(0)
  v_mfma_f32_16x16x32_bf16 v[60:63], v[44:47], v[12:15], 0
  v_mfma_f32_16x16x32_bf16 v[60:63], v[48:51], v[16:19], v[60:63]
  v_mfma_f32_16x16x32_bf16 v[60:63], v[52:55], v[20:23], v[60:63]
  v_mfma_f32_16x16x32_bf16 v[60:63], v[56:59], v[24:27], v[60:63]
  s_nop 7
  v_cvt_pk_bf16_f32 v70, v60, v60
  v_lshlrev_b32 v70, 16, v70
  v_mul_f32 v70, s70, v70
  v_cvt_pk_bf16_f32 v71, v70, v70
  v_lshlrev_b32 v70, 16, v71
  v_mov_b32 v74, v70
  s_nop 1
  v_max_f32_dpp v74, v74, v74 row_ror:8 row_mask:0xf bank_mask:0xf
  s_nop 1
  v_max_f32_dpp v74, v74, v74 row_ror:4 row_mask:0xf bank_mask:0xf
  s_nop 1
  v_max_f32_dpp v74, v74, v74 row_ror:2 row_mask:0xf bank_mask:0xf
  s_nop 1
  v_max_f32_dpp v74, v74, v74 row_ror:1 row_mask:0xf bank_mask:0xf
  v_sub_f32 v70, v70, v74
  v_mul_f32 v70, s71, v70
  v_exp_f32 v70, v70
  s_nop 0
  v_mov_b32 v75, v70
  s_nop 1
  v_add_f32_dpp v75, v75, v75 row_ror:8 row_mask:0xf bank_mask:0xf
  s_nop 1
  v_add_f32_dpp v75, v75, v75 row_ror:4 row_mask:0xf bank_mask:0xf
  s_nop 1
  v_add_f32_dpp v75, v75, v75 row_ror:2 row_mask:0xf bank_mask:0xf
  s_nop 1
  v_add_f32_dpp v75, v75, v75 row_ror:1 row_mask:0xf bank_mask:0xf
  v_cvt_pk_bf16_f32 v71, v70, v70
  v_lshlrev_b32 v72, 16, v71
  v_sub_f32 v72, v70, v72
  v_cvt_pk_bf16_f32 v72, v72, v72
  ds_write_b64 v69, v[74:75]
  ds_bpermute_b32 v76, v6, v71 offset:0
  ds_bpermute_b32 v77, v6, v71 offset:16
  ds_bpermute_b32 v78, v6, v71 offset:32
  ds_bpermute_b32 v79, v6, v71 offset:48
  ds_bpermute_b32 v88, v6, v72 offset:0
  ds_bpermute_b32 v89, v6, v72 offset:16
  ds_bpermute_b32 v90, v6, v72 offset:32
  ds_bpermute_b32 v91, v6, v72 offset:48
  s_waitcnt vmcnt(8) lgkmcnt(7)
  v_and_b32 v80, v8, v76
  v_and_b32 v81, v9, v76
  v_and_b32 v82, v10, v76
  v_and_b32 v83, v11, v76
  s_nop 1
  v_mfma_f32_16x16x32_bf16 v[64:67], v[80:83], v[28:31], 0
  s_waitcnt vmcnt(7) lgkmcnt(6)
  v_and_b32 v80, v8, v77
  v_and_b32 v81, v9, v77
  v_and_b32 v82, v10, v77
  v_and_b32 v83, v11, v77
  s_nop 1
  v_mfma_f32_16x16x32_bf16 v[64:67], v[80:83], v[32:35], v[64:67]
  s_waitcnt vmcnt(6) lgkmcnt(5)
  v_and_b32 v80, v8, v78
  v_and_b32 v81, v9, v78
  v_and_b32 v82, v10, v78
  v_and_b32 v83, v11, v78
  s_nop 1
  v_mfma_f32_16x16x32_bf16 v[64:67], v[80:83], v[36:39], v[64:67]
  s_waitcnt vmcnt(5) lgkmcnt(4)
  v_and_b32 v80, v8, v79
  v_and_b32 v81, v9, v79
  v_and_b32 v82, v10, v79
  v_and_b32 v83, v11, v79
  s_nop 1
  v_mfma_f32_16x16x32_bf16 v[64:67], v[80:83], v[40:43], v[64:67]
  s_waitcnt lgkmcnt(3)
  v_and_b32 v92, v8, v88
  v_and_b32 v93, v9, v88
  v_and_b32 v94, v10, v88
  v_and_b32 v95, v11, v88
  s_nop 1
  v_mfma_f32_16x16x32_bf16 v[64:67], v[92:95], v[28:31], v[64:67]
  s_waitcnt lgkmcnt(2)
  v_and_b32 v92, v8, v89
  v_and_b32 v93, v9, v89
  v_and_b32 v94, v10, v89
  v_and_b32 v95, v11, v89
  s_nop 1
  v_mfma_f32_16x16x32_bf16 v[64:67], v[92:95], v[32:35], v[64:67]
  s_waitcnt lgkmcnt(1)
  v_and_b32 v92, v8, v90
  v_and_b32 v93, v9, v90
  v_and_b32 v94, v10, v90
  v_and_b32 v95, v11, v90
  s_nop 1
  v_mfma_f32_16x16x32_bf16 v[64:67], v[92:95], v[36:39], v[64:67]
  s_waitcnt lgkmcnt(0)
  v_and_b32 v92, v8, v91
  v_and_b32 v93, v9, v91
  v_and_b32 v94, v10, v91
  v_and_b32 v95, v11, v91
  s_nop 1
  v_mfma_f32_16x16x32_bf16 v[64:67], v[92:95], v[40:43], v[64:67]
  s_nop 7
  ds_write_b128 v7, v[64:67]
  s_waitcnt lgkmcnt(0)
  s_barrier
  s_branch L_p2_comb
L_p2_helper:
  v_lshlrev_b32 v3, 4, v2
  s_lshl_b32 s50, s48, 11
  s_mov_b32 s51, 0
L_p2_retry:
  s_add_u32 s52, s50, 0
  buffer_load_dwordx4 v[12:15], v3, s[40:43], s52 offen sc1
  buffer_load_dwordx4 v[16:19], v3, s[40:43], s52 offen offset:1024 sc1
  s_add_u32 s53, s50, 106496
  buffer_load_dwordx4 v[20:23], v3, s[40:43], s53 offen sc1
  buffer_load_dwordx4 v[24:27], v3, s[40:43], s53 offen offset:1024 sc1
  s_add_u32 s54, s50, 212992
  buffer_load_dwordx4 v[28:31], v3, s[40:43], s54 offen sc1
  buffer_load_dwordx4 v[32:35], v3, s[40:43], s54 offen offset:1024 sc1
  s_add_u32 s55, s50, 319488
  buffer_load_dwordx4 v[36:39], v3, s[40:43], s55 offen sc1
  buffer_load_dwordx4 v[40:43], v3, s[40:43], s55 offen offset:1024 sc1
  v_mov_b32 v44, 0
  s_waitcnt vmcnt(7)
  v_xor_b32 v45, s30, v14
  v_xor_b32 v46, s31, v15
  v_or3_b32 v44, v44, v45, v46
  s_waitcnt vmcnt(6)
  v_xor_b32 v45, s30, v18
  v_xor_b32 v46, s31, v19
  v_or3_b32 v44, v44, v45, v46
  s_waitcnt vmcnt(5)
  v_xor_b32 v45, s30, v22
  v_xor_b32 v46, s31, v23
  v_or3_b32 v44, v44, v45, v46
  s_waitcnt vmcnt(4)
  v_xor_b32 v45, s30, v26
  v_xor_b32 v46, s31, v27
  v_or3_b32 v44, v44, v45, v46
  s_waitcnt vmcnt(3)
  v_xor_b32 v45, s30, v30
  v_xor_b32 v46, s31, v31
  v_or3_b32 v44, v44, v45, v46
  s_waitcnt vmcnt(2)
  v_xor_b32 v45, s30, v34
  v_xor_b32 v46, s31, v35
  v_or3_b32 v44, v44, v45, v46
  s_waitcnt vmcnt(1)
  v_xor_b32 v45, s30, v38
  v_xor_b32 v46, s31, v39
  v_or3_b32 v44, v44, v45, v46
  s_waitcnt vmcnt(0)
  v_xor_b32 v45, s30, v42
  v_xor_b32 v46, s31, v43
  v_or3_b32 v44, v44, v45, v46
  v_cmp_ne_u32 vcc, 0, v44
  s_cmp_eq_u64 vcc, 0
  s_nop 3
  s_cbranch_scc1 L_p2_ok
  s_add_u32 s51, s51, 1
  s_sleep 1
  s_cmp_lt_u32 s51, 400000
  s_cbranch_scc1 L_p2_retry
L_p2_ok:
  v_pk_add_f32 v[12:13], v[12:13], v[20:21]
  v_pk_add_f32 v[28:29], v[28:29], v[36:37]
  v_pk_add_f32 v[12:13], v[12:13], v[28:29]
  v_cvt_pk_bf16_f32 v48, v12, v13
  v_pk_add_f32 v[16:17], v[16:17], v[24:25]
  v_pk_add_f32 v[32:33], v[32:33], v[40:41]
  v_pk_add_f32 v[16:17], v[16:17], v[32:33]
  v_cvt_pk_bf16_f32 v49, v16, v17
  v_lshlrev_b32 v4, 2, v2
  ds_write_b32 v4, v48 offset:12288
  ds_write_b32 v4, v49 offset:12544
  s_waitcnt lgkmcnt(0)
  s_barrier
  v_lshlrev_b32 v3, 4, v0
  s_mov_b32 s32, s12
  s_mov_b32 s33, s13
  s_mov_b32 s34, 4718592
  s_mov_b32 s35, 0x20000
  s_mov_b32 s36, s20
  s_mov_b32 s37, s21
  s_mul_i32 s56, s2, 20736
  s_add_u32 s38, s56, 20736
  s_mov_b32 s39, 0x20000
  s_mul_i32 s57, s2, 18432
  s_add_u32 s58, s57, 9216
  s_add_u32 s59, s56, 9216
  s_add_u32 s60, s56, 18432
  buffer_load_dwordx4 v[96:99], v3, s[32:35], s57 offen nt
  buffer_load_dwordx4 v[100:103], v3, s[32:35], s58 offen nt
  buffer_load_dwordx4 v[104:107], v3, s[36:39], s56 offen nt
  buffer_load_dwordx4 v[108:111], v3, s[36:39], s59 offen nt
  buffer_load_dwordx4 v[112:115], v3, s[36:39], s60 offen nt
  s_barrier
L_p2_comb:
  s_cmp_ge_u32 s28, 2
  s_cbranch_scc1 L_p2_end
  s_lshl_b32 s50, s28, 3
  s_add_u32 s50, s50, 20992
  v_mov_b32 v3, s50
  v_lshlrev_b32 v4, 3, v2
  s_lshl_b32 s50, s28, 9
  v_add_u32 v4, s50, v4
  ds_read_b64 v[12:13], v3 offset:0
  ds_read_b64 v[14:15], v3 offset:16
  ds_read_b64 v[16:17], v3 offset:32
  ds_read_b64 v[18:19], v3 offset:48
  ds_read_b64 v[20:21], v3 offset:64
  ds_read_b64 v[22:23], v3 offset:80
  ds_read_b64 v[24:25], v3 offset:96
  ds_read_b64 v[26:27], v3 offset:112
  ds_read_b64 v[28:29], v4 offset:12800
  ds_read_b64 v[30:31], v4 offset:13824
  ds_read_b64 v[32:33], v4 offset:14848
  ds_read_b64 v[34:35], v4 offset:15872
  ds_read_b64 v[36:37], v4 offset:16896
  ds_read_b64 v[38:39], v4 offset:17920
  ds_read_b64 v[40:41], v4 offset:18944
  ds_read_b64 v[42:43], v4 offset:19968
  s_lshl_b32 s51, s48, 1
  s_add_u32 s51, s51, s28
  s_lshl_b32 s51, s51, 4
  s_add_u32 s51, s51, s49
  s_lshl_b32 s52, s51, 10
  s_add_u32 s52, s52, 524288
  s_lshl_b32 s53, s51, 7
  s_add_u32 s53, s53, 1048576
  s_waitcnt lgkmcnt(8)
  v_max3_f32 v48, v12, v14, v16
  v_max3_f32 v48, v48, v18, v20
  v_max3_f32 v48, v48, v22, v24
  v_max_f32 v48, v48, v26
  v_sub_f32 v52, v12, v48
  v_sub_f32 v53, v14, v48
  v_sub_f32 v54, v16, v48
  v_sub_f32 v55, v18, v48
  v_sub_f32 v56, v20, v48
  v_sub_f32 v57, v22, v48
  v_sub_f32 v58, v24, v48
  v_sub_f32 v59, v26, v48
  v_mul_f32 v52, s71, v52
  v_mul_f32 v53, s71, v53
  v_mul_f32 v54, s71, v54
  v_mul_f32 v55, s71, v55
  v_mul_f32 v56, s71, v56
  v_mul_f32 v57, s71, v57
  v_mul_f32 v58, s71, v58
  v_mul_f32 v59, s71, v59
  v_exp_f32 v52, v52
  v_exp_f32 v53, v53
  v_exp_f32 v54, v54
  v_exp_f32 v55, v55
  v_exp_f32 v56, v56
  v_exp_f32 v57, v57
  v_exp_f32 v58, v58
  v_exp_f32 v59, v59
  v_mul_f32 v49, v52, v13
  v_fmac_f32 v49, v53, v15
  v_fmac_f32 v49, v54, v17
  v_fmac_f32 v49, v55, v19
  v_fmac_f32 v49, v56, v21
  v_fmac_f32 v49, v57, v23
  v_fmac_f32 v49, v58, v25
  v_fmac_f32 v49, v59, v27
  v_mov_b32 v50, s30
  v_mov_b32 v51, s31
  s_waitcnt lgkmcnt(0)
  v_mul_f32 v60, v52, v28
  v_mul_f32 v61, v52, v29
  v_fmac_f32 v60, v53, v30
  v_fmac_f32 v61, v53, v31
  v_fmac_f32 v60, v54, v32
  v_fmac_f32 v61, v54, v33
  v_fmac_f32 v60, v55, v34
  v_fmac_f32 v61, v55, v35
  v_fmac_f32 v60, v56, v36
  v_fmac_f32 v61, v56, v37
  v_fmac_f32 v60, v57, v38
  v_fmac_f32 v61, v57, v39
  v_fmac_f32 v60, v58, v40
  v_fmac_f32 v61, v58, v41
  v_fmac_f32 v60, v59, v42
  v_fmac_f32 v61, v59, v43
  v_mov_b32 v62, s30
  v_mov_b32 v63, s31
  v_lshlrev_b32 v6, 4, v2
  buffer_store_dwordx4 v[60:63], v6, s[40:43], s52 offen sc1
  s_mov_b64 s[54:55], exec
  s_mov_b64 exec, 1
  buffer_store_dwordx4 v[48:51], v6, s[40:43], s53 offen sc1
  s_mov_b64 exec, s[54:55]
L_p2_end:
  v_mul_u32_u24 v4, 911, v0
  v_lshrrev_b32 v4, 16, v4
  v_mul_u32_u24 v5, 72, v4
  v_sub_u32 v5, v0, v5
  s_cmp_lg_u32 s28, 0
  s_nop 0
  s_cbranch_scc1 L_p3_a
  s_lshr_b32 s53, s2, 3
  s_and_b32 s54, s2, 7
  v_and_b32 v6, 15, v2
  v_lshrrev_b32 v7, 4, v2
  v_lshlrev_b32 v8, 10, v6
  v_lshl_add_u32 v8, v7, 4, v8
  s_lshl_b32 s55, s53, 14
  s_lshl_b32 s56, s54, 7
  s_add_u32 s55, s55, s56
  s_add_u32 s55, s55, 524288
  v_lshlrev_b32 v9, 7, v6
  s_lshl_b32 s56, s53, 11
  s_add_u32 s56, s56, 1048576
  v_min_u32 v10, 8, v2
  v_lshlrev_b32 v11, 4, v10
  s_mul_i32 s57, s2, 144
  s_mov_b32 s58, 0
L_p3_retry:
  buffer_load_dwordx4 v[12:15], v9, s[40:43], s56 offen sc1
  buffer_load_dwordx4 v[16:19], v8, s[40:43], s55 offen sc1
  buffer_load_dwordx4 v[20:23], v8, s[40:43], s55 offen offset:64 sc1
  s_add_u32 s59, s57, 32768
  buffer_load_dwordx4 v[32:35], v11, s[40:43], s59 offen sc1
  s_add_u32 s60, s57, 69632
  buffer_load_dwordx4 v[36:39], v11, s[40:43], s60 offen sc1
  s_add_u32 s59, s57, 139264
  buffer_load_dwordx4 v[40:43], v11, s[40:43], s59 offen sc1
  s_add_u32 s60, s57, 176128
  buffer_load_dwordx4 v[44:47], v11, s[40:43], s60 offen sc1
  s_add_u32 s59, s57, 245760
  buffer_load_dwordx4 v[48:51], v11, s[40:43], s59 offen sc1
  s_add_u32 s60, s57, 282624
  buffer_load_dwordx4 v[52:55], v11, s[40:43], s60 offen sc1
  s_add_u32 s59, s57, 352256
  buffer_load_dwordx4 v[56:59], v11, s[40:43], s59 offen sc1
  s_add_u32 s60, s57, 389120
  buffer_load_dwordx4 v[60:63], v11, s[40:43], s60 offen sc1
  v_mov_b32 v24, 0
  s_waitcnt vmcnt(10)
  v_xor_b32 v25, s30, v14
  v_xor_b32 v26, s31, v15
  v_or3_b32 v24, v24, v25, v26
  s_waitcnt vmcnt(9)
  v_xor_b32 v25, s30, v18
  v_xor_b32 v26, s31, v19
  v_or3_b32 v24, v24, v25, v26
  s_waitcnt vmcnt(8)
  v_xor_b32 v25, s30, v22
  v_xor_b32 v26, s31, v23
  v_or3_b32 v24, v24, v25, v26
  s_waitcnt vmcnt(7)
  v_xor_b32 v25, s30, v34
  v_xor_b32 v26, s31, v35
  v_or3_b32 v24, v24, v25, v26
  s_waitcnt vmcnt(6)
  v_xor_b32 v25, s30, v38
  v_xor_b32 v26, s31, v39
  v_or3_b32 v24, v24, v25, v26
  s_waitcnt vmcnt(5)
  v_xor_b32 v25, s30, v42
  v_xor_b32 v26, s31, v43
  v_or3_b32 v24, v24, v25, v26
  s_waitcnt vmcnt(4)
  v_xor_b32 v25, s30, v46
  v_xor_b32 v26, s31, v47
  v_or3_b32 v24, v24, v25, v26
  s_waitcnt vmcnt(3)
  v_xor_b32 v25, s30, v50
  v_xor_b32 v26, s31, v51
  v_or3_b32 v24, v24, v25, v26
  s_waitcnt vmcnt(2)
  v_xor_b32 v25, s30, v54
  v_xor_b32 v26, s31, v55
  v_or3_b32 v24, v24, v25, v26
  s_waitcnt vmcnt(1)
  v_xor_b32 v25, s30, v58
  v_xor_b32 v26, s31, v59
  v_or3_b32 v24, v24, v25, v26
  s_waitcnt vmcnt(0)
  v_xor_b32 v25, s30, v62
  v_xor_b32 v26, s31, v63
  v_or3_b32 v24, v24, v25, v26
  v_cmp_ne_u32 vcc, 0, v24
  s_cmp_eq_u64 vcc, 0
  s_nop 3
  s_cbranch_scc1 L_p3_ok
  s_add_u32 s58, s58, 1
  s_sleep 1
  s_cmp_lt_u32 s58, 400000
  s_cbranch_scc1 L_p3_retry
L_p3_ok:
  v_mov_b32 v14, v12
  s_nop 1
  v_max_f32_dpp v14, v14, v14 row_ror:8 row_mask:0xf bank_mask:0xf
  s_nop 1
  v_max_f32_dpp v14, v14, v14 row_ror:4 row_mask:0xf bank_mask:0xf
  s_nop 1
  v_max_f32_dpp v14, v14, v14 row_ror:2 row_mask:0xf bank_mask:0xf
  s_nop 1
  v_max_f32_dpp v14, v14, v14 row_ror:1 row_mask:0xf bank_mask:0xf
  v_sub_f32 v12, v12, v14
  v_mul_f32 v12, s71, v12
  v_exp_f32 v12, v12
  s_nop 0
  v_mul_f32 v13, v12, v13
  s_nop 1
  v_add_f32_dpp v13, v13, v13 row_ror:8 row_mask:0xf bank_mask:0xf
  s_nop 1
  v_add_f32_dpp v13, v13, v13 row_ror:4 row_mask:0xf bank_mask:0xf
  s_nop 1
  v_add_f32_dpp v13, v13, v13 row_ror:2 row_mask:0xf bank_mask:0xf
  s_nop 1
  v_add_f32_dpp v13, v13, v13 row_ror:1 row_mask:0xf bank_mask:0xf
  v_rcp_f32 v14, v13
  s_nop 0
  v_fma_f32 v15, -v13, v14, 1.0
  v_fma_f32 v14, v15, v14, v14
  v_mul_f32 v12, v12, v14
  v_mul_f32 v16, v12, v16
  v_mul_f32 v17, v12, v17
  v_mul_f32 v20, v12, v20
  v_mul_f32 v21, v12, v21
  v_add_f32_dpp v16, v16, v16 row_ror:8 row_mask:0xf bank_mask:0xf
  v_add_f32_dpp v17, v17, v17 row_ror:8 row_mask:0xf bank_mask:0xf
  v_add_f32_dpp v20, v20, v20 row_ror:8 row_mask:0xf bank_mask:0xf
  v_add_f32_dpp v21, v21, v21 row_ror:8 row_mask:0xf bank_mask:0xf
  v_add_f32_dpp v16, v16, v16 row_ror:4 row_mask:0xf bank_mask:0xf
  v_add_f32_dpp v17, v17, v17 row_ror:4 row_mask:0xf bank_mask:0xf
  v_add_f32_dpp v20, v20, v20 row_ror:4 row_mask:0xf bank_mask:0xf
  v_add_f32_dpp v21, v21, v21 row_ror:4 row_mask:0xf bank_mask:0xf
  v_add_f32_dpp v16, v16, v16 row_ror:2 row_mask:0xf bank_mask:0xf
  v_add_f32_dpp v17, v17, v17 row_ror:2 row_mask:0xf bank_mask:0xf
  v_add_f32_dpp v20, v20, v20 row_ror:2 row_mask:0xf bank_mask:0xf
  v_add_f32_dpp v21, v21, v21 row_ror:2 row_mask:0xf bank_mask:0xf
  v_add_f32_dpp v16, v16, v16 row_ror:1 row_mask:0xf bank_mask:0xf
  v_add_f32_dpp v17, v17, v17 row_ror:1 row_mask:0xf bank_mask:0xf
  v_add_f32_dpp v20, v20, v20 row_ror:1 row_mask:0xf bank_mask:0xf
  v_add_f32_dpp v21, v21, v21 row_ror:1 row_mask:0xf bank_mask:0xf
  v_cvt_pk_bf16_f32 v24, v16, v17
  v_lshlrev_b32 v16, 16, v24
  v_and_b32 v17, s29, v24
  v_cvt_pk_bf16_f32 v24, v20, v21
  v_lshlrev_b32 v20, 16, v24
  v_and_b32 v21, s29, v24
  v_lshlrev_b32 v7, 4, v7
  ds_write_b32 v7, v16 offset:21504
  ds_write_b32 v7, v17 offset:21512
  ds_write_b32 v7, v20 offset:21508
  ds_write_b32 v7, v21 offset:21516
  v_pk_add_f32 v[32:33], v[32:33], v[40:41]
  v_pk_add_f32 v[48:49], v[48:49], v[56:57]
  v_pk_add_f32 v[32:33], v[32:33], v[48:49]
  v_pk_add_f32 v[36:37], v[36:37], v[44:45]
  v_pk_add_f32 v[52:53], v[52:53], v[60:61]
  v_pk_add_f32 v[36:37], v[36:37], v[52:53]
  v_cvt_pk_bf16_f32 v24, v32, v33
  v_lshlrev_b32 v32, 16, v24
  v_and_b32 v33, s29, v24
  v_cvt_pk_bf16_f32 v24, v36, v37
  v_lshlrev_b32 v36, 16, v24
  v_and_b32 v37, s29, v24
  s_mov_b32 s59, 0xc2fc0000
  v_mul_f32 v24, s71, v32
  v_max_f32 v24, s59, v24
  v_exp_f32 v24, -v24
  s_nop 0
  v_add_f32 v24, 1.0, v24
  v_rcp_f32 v25, v24
  s_nop 0
  v_fma_f32 v26, -v24, v25, 1.0
  v_fma_f32 v25, v26, v25, v25
  v_mul_f32 v32, v32, v25
  v_mul_f32 v24, s71, v33
  v_max_f32 v24, s59, v24
  v_exp_f32 v24, -v24
  s_nop 0
  v_add_f32 v24, 1.0, v24
  v_rcp_f32 v25, v24
  s_nop 0
  v_fma_f32 v26, -v24, v25, 1.0
  v_fma_f32 v25, v26, v25, v25
  v_mul_f32 v33, v33, v25
  v_cvt_pk_bf16_f32 v24, v32, v33
  v_lshlrev_b32 v32, 16, v24
  v_and_b32 v33, s29, v24
  v_mul_f32 v32, v32, v36
  v_mul_f32 v33, v33, v37
  v_cvt_pk_bf16_f32 v24, v32, v33
  v_lshlrev_b32 v32, 16, v24
  v_and_b32 v33, s29, v24
  v_lshlrev_b32 v24, 1, v10
  v_and_b32 v25, 7, v24
  v_lshlrev_b32 v25, 4, v25
  v_lshrrev_b32 v26, 3, v24
  v_lshl_add_u32 v25, v26, 2, v25
  ds_write_b32 v25, v32 offset:21632
  ds_write_b32 v25, v33 offset:21648
  v_subrev_u32 v24, 16, v2
  v_lshlrev_b32 v24, 4, v24
  v_mov_b32 v25, 0
  v_cmp_gt_u32 vcc, 8, v24
  v_subrev_u32 v26, 18, v2
  v_cmp_gt_u32 vcc, 6, v26
  s_and_saveexec_b64 s[60:61], vcc
  ds_write_b32 v24, v25 offset:21640
  s_mov_b64 exec, s[60:61]
  s_waitcnt lgkmcnt(0)
L_p3_a:
  s_barrier
  v_lshlrev_b32 v6, 3, v4
  ds_read_b64 v[24:25], v6 offset:21504
  v_lshlrev_b32 v6, 4, v4
  ds_read_b96 v[28:30], v6 offset:21632
  v_mul_u32_u24 v8, 2304, v4
  v_lshl_add_u32 v8, v5, 5, v8
  s_waitcnt vmcnt(0) lgkmcnt(0)
  v_lshlrev_b32 v68, 16, v96
  v_and_b32 v69, s29, v96
  v_mul_f32 v52, v24, v68
  v_mul_f32 v53, v24, v69
  v_lshlrev_b32 v70, 16, v97
  v_and_b32 v71, s29, v97
  v_mul_f32 v54, v24, v70
  v_mul_f32 v55, v24, v71
  v_lshlrev_b32 v68, 16, v98
  v_and_b32 v69, s29, v98
  v_mul_f32 v56, v24, v68
  v_mul_f32 v57, v24, v69
  v_lshlrev_b32 v70, 16, v99
  v_and_b32 v71, s29, v99
  v_mul_f32 v58, v24, v70
  v_mul_f32 v59, v24, v71
  v_lshlrev_b32 v68, 16, v100
  v_and_b32 v69, s29, v100
  v_fmac_f32 v52, v25, v68
  v_fmac_f32 v53, v25, v69
  v_lshlrev_b32 v70, 16, v101
  v_and_b32 v71, s29, v101
  v_fmac_f32 v54, v25, v70
  v_fmac_f32 v55, v25, v71
  v_lshlrev_b32 v68, 16, v102
  v_and_b32 v69, s29, v102
  v_fmac_f32 v56, v25, v68
  v_fmac_f32 v57, v25, v69
  v_lshlrev_b32 v70, 16, v103
  v_and_b32 v71, s29, v103
  v_fmac_f32 v58, v25, v70
  v_fmac_f32 v59, v25, v71
  v_lshlrev_b32 v68, 16, v104
  v_and_b32 v69, s29, v104
  v_mul_f32 v60, v28, v68
  v_mul_f32 v61, v28, v69
  v_lshlrev_b32 v70, 16, v105
  v_and_b32 v71, s29, v105
  v_mul_f32 v62, v28, v70
  v_mul_f32 v63, v28, v71
  v_lshlrev_b32 v68, 16, v106
  v_and_b32 v69, s29, v106
  v_mul_f32 v64, v28, v68
  v_mul_f32 v65, v28, v69
  v_lshlrev_b32 v70, 16, v107
  v_and_b32 v71, s29, v107
  v_mul_f32 v66, v28, v70
  v_mul_f32 v67, v28, v71
  v_lshlrev_b32 v68, 16, v108
  v_and_b32 v69, s29, v108
  v_fmac_f32 v60, v29, v68
  v_fmac_f32 v61, v29, v69
  v_lshlrev_b32 v70, 16, v109
  v_and_b32 v71, s29, v109
  v_fmac_f32 v62, v29, v70
  v_fmac_f32 v63, v29, v71
  v_lshlrev_b32 v68, 16, v110
  v_and_b32 v69, s29, v110
  v_fmac_f32 v64, v29, v68
  v_fmac_f32 v65, v29, v69
  v_lshlrev_b32 v70, 16, v111
  v_and_b32 v71, s29, v111
  v_fmac_f32 v66, v29, v70
  v_fmac_f32 v67, v29, v71
  v_lshlrev_b32 v68, 16, v112
  v_and_b32 v69, s29, v112
  v_fmac_f32 v60, v30, v68
  v_fmac_f32 v61, v30, v69
  v_lshlrev_b32 v70, 16, v113
  v_and_b32 v71, s29, v113
  v_fmac_f32 v62, v30, v70
  v_fmac_f32 v63, v30, v71
  v_lshlrev_b32 v68, 16, v114
  v_and_b32 v69, s29, v114
  v_fmac_f32 v64, v30, v68
  v_fmac_f32 v65, v30, v69
  v_lshlrev_b32 v70, 16, v115
  v_and_b32 v71, s29, v115
  v_fmac_f32 v66, v30, v70
  v_fmac_f32 v67, v30, v71
  ds_write_b128 v8, v[52:55] offset:22528
  ds_write_b128 v8, v[56:59] offset:22544
  ds_write_b128 v8, v[60:63] offset:40960
  ds_write_b128 v8, v[64:67] offset:40976
  s_waitcnt lgkmcnt(0)
  s_barrier
  v_lshlrev_b32 v9, 2, v0
  ds_read_b32 v32, v9 offset:22528
  ds_read_b32 v33, v9 offset:24832
  ds_read_b32 v34, v9 offset:27136
  ds_read_b32 v35, v9 offset:29440
  ds_read_b32 v36, v9 offset:31744
  ds_read_b32 v37, v9 offset:34048
  ds_read_b32 v38, v9 offset:36352
  ds_read_b32 v39, v9 offset:38656
  ds_read_b32 v40, v9 offset:40960
  ds_read_b32 v41, v9 offset:43264
  ds_read_b32 v42, v9 offset:45568
  ds_read_b32 v43, v9 offset:47872
  ds_read_b32 v44, v9 offset:50176
  ds_read_b32 v45, v9 offset:52480
  ds_read_b32 v46, v9 offset:54784
  ds_read_b32 v47, v9 offset:57088
  v_lshlrev_b32 v10, 4, v0
  s_mul_i32 s48, s2, 9216
  s_add_u32 s48, s48, 2097152
  s_waitcnt lgkmcnt(8)
  v_add_f32 v32, v32, v33
  v_add_f32 v34, v34, v35
  v_add_f32 v36, v36, v37
  v_add_f32 v38, v38, v39
  v_add_f32 v32, v32, v34
  v_add_f32 v36, v36, v38
  v_add_f32 v48, v32, v36
  s_waitcnt lgkmcnt(0)
  v_add_f32 v40, v40, v41
  v_add_f32 v42, v42, v43
  v_add_f32 v44, v44, v45
  v_add_f32 v46, v46, v47
  v_add_f32 v40, v40, v42
  v_add_f32 v44, v44, v46
  v_add_f32 v49, v40, v44
  v_mov_b32 v50, s30
  v_mov_b32 v51, s31
  buffer_store_dwordx4 v[48:51], v10, s[40:43], s48 offen sc1
  s_cmp_ge_u32 s2, 144
  s_nop 0
  s_cbranch_scc1 L_end
  s_cmp_lg_u32 s28, 0
  s_cbranch_scc1 L_end
  s_mov_b32 s32, s4
  s_mov_b32 s33, s5
  s_mov_b32 s34, 1152
  s_mov_b32 s35, 0x20000
  s_mov_b32 s36, s22
  s_mov_b32 s37, s23
  s_mov_b32 s38, 1152
  s_mov_b32 s39, 0x20000
  v_and_b32 v3, 3, v2
  v_lshlrev_b32 v4, 1, v3
  s_lshl_b32 s48, s2, 3
  buffer_load_ushort v80, v4, s[32:35], s48 offen
  v_lshrrev_b32 v5, 2, v2
  v_mul_u32_u24 v5, 9216, v5
  v_lshl_add_u32 v5, v3, 4, v5
  s_lshl_b32 s49, s2, 6
  s_mov_b32 s50, 0
  s_add_u32 s51, s49, 2097152
  s_add_u32 s52, s49, 2244608
  s_add_u32 s53, s49, 2392064
  s_add_u32 s54, s49, 2539520
  s_add_u32 s55, s49, 2686976
  s_add_u32 s56, s49, 2834432
  s_add_u32 s57, s49, 2981888
  s_add_u32 s58, s49, 3129344
  s_add_u32 s59, s49, 3276800
  s_add_u32 s60, s49, 3424256
  s_add_u32 s61, s49, 3571712
  s_add_u32 s62, s49, 3719168
  s_add_u32 s63, s49, 3866624
  s_add_u32 s64, s49, 4014080
  s_add_u32 s65, s49, 4161536
  s_add_u32 s66, s49, 4308992
L_p4_retry:
  buffer_load_dwordx4 v[8:11], v5, s[40:43], s51 offen sc1
  buffer_load_dwordx4 v[12:15], v5, s[40:43], s52 offen sc1
  buffer_load_dwordx4 v[16:19], v5, s[40:43], s53 offen sc1
  buffer_load_dwordx4 v[20:23], v5, s[40:43], s54 offen sc1
  buffer_load_dwordx4 v[24:27], v5, s[40:43], s55 offen sc1
  buffer_load_dwordx4 v[28:31], v5, s[40:43], s56 offen sc1
  buffer_load_dwordx4 v[32:35], v5, s[40:43], s57 offen sc1
  buffer_load_dwordx4 v[36:39], v5, s[40:43], s58 offen sc1
  buffer_load_dwordx4 v[40:43], v5, s[40:43], s59 offen sc1
  buffer_load_dwordx4 v[44:47], v5, s[40:43], s60 offen sc1
  buffer_load_dwordx4 v[48:51], v5, s[40:43], s61 offen sc1
  buffer_load_dwordx4 v[52:55], v5, s[40:43], s62 offen sc1
  buffer_load_dwordx4 v[56:59], v5, s[40:43], s63 offen sc1
  buffer_load_dwordx4 v[60:63], v5, s[40:43], s64 offen sc1
  buffer_load_dwordx4 v[64:67], v5, s[40:43], s65 offen sc1
  buffer_load_dwordx4 v[68:71], v5, s[40:43], s66 offen sc1
  v_mov_b32 v72, 0
  s_waitcnt vmcnt(15)
  v_xor_b32 v73, s30, v10
  v_xor_b32 v74, s31, v11
  v_or3_b32 v72, v72, v73, v74
  s_waitcnt vmcnt(14)
  v_xor_b32 v73, s30, v14
  v_xor_b32 v74, s31, v15
  v_or3_b32 v72, v72, v73, v74
  s_waitcnt vmcnt(13)
  v_xor_b32 v73, s30, v18
  v_xor_b32 v74, s31, v19
  v_or3_b32 v72, v72, v73, v74
  s_waitcnt vmcnt(12)
  v_xor_b32 v73, s30, v22
  v_xor_b32 v74, s31, v23
  v_or3_b32 v72, v72, v73, v74
  s_waitcnt vmcnt(11)
  v_xor_b32 v73, s30, v26
  v_xor_b32 v74, s31, v27
  v_or3_b32 v72, v72, v73, v74
  s_waitcnt vmcnt(10)
  v_xor_b32 v73, s30, v30
  v_xor_b32 v74, s31, v31
  v_or3_b32 v72, v72, v73, v74
  s_waitcnt vmcnt(9)
  v_xor_b32 v73, s30, v34
  v_xor_b32 v74, s31, v35
  v_or3_b32 v72, v72, v73, v74
  s_waitcnt vmcnt(8)
  v_xor_b32 v73, s30, v38
  v_xor_b32 v74, s31, v39
  v_or3_b32 v72, v72, v73, v74
  s_waitcnt vmcnt(7)
  v_xor_b32 v73, s30, v42
  v_xor_b32 v74, s31, v43
  v_or3_b32 v72, v72, v73, v74
  s_waitcnt vmcnt(6)
  v_xor_b32 v73, s30, v46
  v_xor_b32 v74, s31, v47
  v_or3_b32 v72, v72, v73, v74
  s_waitcnt vmcnt(5)
  v_xor_b32 v73, s30, v50
  v_xor_b32 v74, s31, v51
  v_or3_b32 v72, v72, v73, v74
  s_waitcnt vmcnt(4)
  v_xor_b32 v73, s30, v54
  v_xor_b32 v74, s31, v55
  v_or3_b32 v72, v72, v73, v74
  s_waitcnt vmcnt(3)
  v_xor_b32 v73, s30, v58
  v_xor_b32 v74, s31, v59
  v_or3_b32 v72, v72, v73, v74
  s_waitcnt vmcnt(2)
  v_xor_b32 v73, s30, v62
  v_xor_b32 v74, s31, v63
  v_or3_b32 v72, v72, v73, v74
  s_waitcnt vmcnt(1)
  v_xor_b32 v73, s30, v66
  v_xor_b32 v74, s31, v67
  v_or3_b32 v72, v72, v73, v74
  s_waitcnt vmcnt(0)
  v_xor_b32 v73, s30, v70
  v_xor_b32 v74, s31, v71
  v_or3_b32 v72, v72, v73, v74
  v_cmp_ne_u32 vcc, 0, v72
  s_cmp_eq_u64 vcc, 0
  s_nop 3
  s_cbranch_scc1 L_p4_ok
  s_add_u32 s50, s50, 1
  s_sleep 1
  s_cmp_lt_u32 s50, 400000
  s_cbranch_scc1 L_p4_retry
L_p4_ok:
  v_pk_add_f32 v[8:9], v[8:9], v[12:13]
  v_pk_add_f32 v[16:17], v[16:17], v[20:21]
  v_pk_add_f32 v[24:25], v[24:25], v[28:29]
  v_pk_add_f32 v[32:33], v[32:33], v[36:37]
  v_pk_add_f32 v[40:41], v[40:41], v[44:45]
  v_pk_add_f32 v[48:49], v[48:49], v[52:53]
  v_pk_add_f32 v[56:57], v[56:57], v[60:61]
  v_pk_add_f32 v[64:65], v[64:65], v[68:69]
  v_pk_add_f32 v[8:9], v[8:9], v[16:17]
  v_pk_add_f32 v[24:25], v[24:25], v[32:33]
  v_pk_add_f32 v[40:41], v[40:41], v[48:49]
  v_pk_add_f32 v[56:57], v[56:57], v[64:65]
  v_pk_add_f32 v[8:9], v[8:9], v[24:25]
  v_pk_add_f32 v[40:41], v[40:41], v[56:57]
  v_pk_add_f32 v[8:9], v[8:9], v[40:41]
  s_nop 1
  v_add_f32_dpp v8, v8, v8 row_ror:8 row_mask:0xf bank_mask:0xf
  v_add_f32_dpp v9, v9, v9 row_ror:8 row_mask:0xf bank_mask:0xf
  s_nop 0
  v_add_f32_dpp v8, v8, v8 row_ror:4 row_mask:0xf bank_mask:0xf
  v_add_f32_dpp v9, v9, v9 row_ror:4 row_mask:0xf bank_mask:0xf
  v_mov_b32 v12, v8
  v_mov_b32 v13, v9
  s_nop 0
  v_permlane16_swap_b32 v8, v12
  v_permlane16_swap_b32 v9, v13
  v_add_f32 v8, v8, v12
  v_add_f32 v9, v9, v13
  v_mov_b32 v12, v8
  v_mov_b32 v13, v9
  s_nop 0
  v_permlane32_swap_b32 v8, v12
  v_permlane32_swap_b32 v9, v13
  v_add_f32 v8, v8, v12
  v_add_f32 v9, v9, v13
  v_cvt_pk_bf16_f32 v12, v8, v9
  v_lshlrev_b32 v8, 16, v12
  v_and_b32 v9, s29, v12
  s_mov_b32 s51, 0xc2fc0000
  v_mul_f32 v12, s71, v9
  v_max_f32 v12, s51, v12
  v_exp_f32 v12, -v12
  s_nop 0
  v_add_f32 v12, 1.0, v12
  v_rcp_f32 v13, v12
  s_nop 0
  v_fma_f32 v14, -v12, v13, 1.0
  v_fma_f32 v13, v14, v13, v13
  v_mul_f32 v9, v9, v13
  v_cvt_pk_bf16_f32 v12, v9, v9
  v_lshlrev_b32 v9, 16, v12
  v_mul_f32 v8, v8, v9
  v_cvt_pk_bf16_f32 v12, v8, v8
  v_lshlrev_b32 v8, 16, v12
  v_lshlrev_b32 v12, 16, v80
  v_add_f32 v8, v12, v8
  v_cvt_pk_bf16_f32 v8, v8, v8
  s_mov_b64 exec, 15
  buffer_store_short v8, v4, s[36:39], s48 offen
  s_mov_b64 exec, -1
L_end:
L_exit:
  s_endpgm
L_code_end:
.section .rodata,"a"
.p2align 6
.amdhsa_kernel recurrent_scan__sliding_block_cached__swiglu_ffn__decode_kernel
.amdhsa_next_free_vgpr 128
.amdhsa_next_free_sgpr 102
.amdhsa_accum_offset 128
.amdhsa_group_segment_fixed_size 0
.amdhsa_kernarg_size 96
.amdhsa_user_sgpr_count 2
.amdhsa_user_sgpr_kernarg_segment_ptr 1
.amdhsa_system_sgpr_workgroup_id_x 1
.end_amdhsa_kernel
```
